```python
import torch

def _softmax(x, axis=-1):
    return torch.softmax(x, dim=axis)
def _gelu(x):
    return torch.nn.functional.gelu(x, approximate="tanh")
def _silu(x):
    return torch.nn.functional.silu(x)
def _sigmoid(x):
    return torch.sigmoid(x)
def _layernorm(x, axis=-1, eps=1e-5):
    m = x.mean(dim=axis, keepdim=True)
    v = x.var(dim=axis, keepdim=True, unbiased=False)
    return (x - m) / torch.sqrt(v + eps)
def _scatter_add(tgt, idx, src, axis=0):
    return tgt.clone().index_add_(axis, idx, src)
def _segment_sum(src, seg, n):
    out = torch.zeros((n,) + src.shape[1:], dtype=src.dtype)
    return out.index_add_(0, seg, src)
def _pad(x, pw):
    flat = tuple(v for pair in reversed(pw) for v in pair)
    return torch.nn.functional.pad(x, flat)

kernel_name = 'standalone__sliding_block_cached__decode'

def setup_inputs():

    _w = (lambda a: (lambda t: t.to(torch.bfloat16) if t.is_floating_point() else t)(torch.as_tensor(a)))
    B, Sq, D = 4, 1, 512
    Hq, Hkv, Sk, Dh = 32, 8, 16384, 128
    assert Hq % Hkv == 0, (Hq, Hkv)
    return {
        "x": _w((lambda *s: torch.randn(*s, dtype=torch.bfloat16) * 0.8)(B, Sq, D)),
        "k_cache": _w((lambda *s: torch.randn(*s, dtype=torch.bfloat16) * 0.8)(B, Hkv, Sk, Dh)),
        "v_cache": _w((lambda *s: torch.randn(*s, dtype=torch.bfloat16) * 0.05)(B, Hkv, Sk, Dh)),
        "wq": _w((lambda *s: torch.randn(*s, dtype=torch.bfloat16) * 0.8)(D, Hq * Dh) * (D ** -0.5)),
        "wo": _w((lambda *s: torch.randn(*s, dtype=torch.bfloat16) * 0.05)(Hq * Dh, D) * ((Hq * Dh) ** -0.5)),
    }

def reference(x, k_cache, v_cache, wq, wo):
    B, Sq, D = x.shape
    Hq, Dh = 32, 128
    Hkv, Sk = k_cache.shape[1], k_cache.shape[2]
    W = min(4096, max(256, Sk // 4))
    rep = Hq // Hkv
    q = (lambda x, *d: x.permute(*d))((x @ wq).reshape(B, Sq, Hq, Dh), 0, 2, 1, 3)
    k = (lambda x, n, axis: torch.repeat_interleave(x, n, dim=axis))(k_cache[:, :, Sk - W:, :], rep, axis=1)
    v = (lambda x, n, axis: torch.repeat_interleave(x, n, dim=axis))(v_cache[:, :, Sk - W:, :], rep, axis=1)
    scores = torch.einsum("bhqd,bhkd->bhqk", q, k) * (Dh ** -0.5)
    p = _softmax(scores, axis=-1)
    o = torch.einsum("bhqk,bhkd->bhqd", p, v)
    return (lambda x, *d: x.permute(*d))(o, 0, 2, 1, 3).reshape(B, Sq, Hq * Dh) @ wo
```

```asm
; @launch grid=(256,1,1) block=(512,1,1) lds=147456
.amdgcn_target "amdgcn-amd-amdhsa--gfx950"
.text
.globl standalone__sliding_block_cached__decode_kernel
.p2align 8
.type standalone__sliding_block_cached__decode_kernel,@function
standalone__sliding_block_cached__decode_kernel:
    s_load_dwordx16 s[64:79], s[0:1], 0
    v_readfirstlane_b32 s3, v0
    s_lshr_b32 s5, s2, 3
    s_cmp_ge_u32 s5, 32
    s_cbranch_scc1 L_end
    s_lshr_b32 s3, s3, 6
    s_cmp_lt_u32 s3, 4
    s_cbranch_scc1 L_vwave
    s_getpc_b64 s[52:53]
L_pfbase:
    v_and_b32 v2, 0xff, v0
    v_lshlrev_b32 v2, 6, v2
    v_min_u32 v2, L_last-L_pfbase, v2
    global_load_dword v250, v2, s[52:53]
    v_and_b32 v0, 63, v0
    s_and_b32 s4, s2, 7
    v_lshrrev_b32 v4, 4, v0
    v_and_b32 v5, 15, v0
    s_and_b32 s41, s3, 3
    s_setprio 2
    s_lshr_b32 s6, s5, 3
    s_and_b32 s7, s5, 7
    s_lshl_b32 s37, s6, 3
    s_add_u32 s37, s37, s4
    s_lshl_b32 s37, s37, 7
    s_add_u32 s37, s37, s7
    s_add_u32 s37, s37, 96
    s_lshl_b32 s37, s37, 15
    s_lshl_b32 s38, s41, 1
    s_add_u32 s38, s38, s6
    s_add_u32 s38, s38, s5
    s_add_u32 s38, s38, s2
    v_lshlrev_b32 v3, 2, v4
    v_xor_b32 v3, v3, v5
    v_lshlrev_b32 v3, 4, v3
    v_lshl_add_u32 v8, v4, 8, v3
    v_xor_b32 v9, 16, v8
    v_xor_b32 v10, 32, v8
    v_xor_b32 v11, 48, v8
    s_lshl_b32 s45, s41, 15
    s_add_u32 s45, s45, 0x4000
    s_mov_b32 m0, s45
    s_mov_b32 s42, 3
    s_mov_b32 s14, 0x8000000
    s_mov_b32 s15, 0x20000
    s_waitcnt lgkmcnt(0)
    s_mov_b64 s[12:13], s[66:67]
    s_and_b32 s40, s38, 7
    s_lshl_b32 s40, s40, 12
    s_add_u32 s40, s40, s37
    buffer_load_dwordx4 v8, s[12:15], s40 offen offset:0 nt lds
    buffer_load_dwordx4 v9, s[12:15], s40 offen offset:1024 nt lds
    buffer_load_dwordx4 v10, s[12:15], s40 offen offset:2048 nt lds
    buffer_load_dwordx4 v11, s[12:15], s40 offen offset:3072 nt lds
    s_add_u32 m0, m0, 0x1000
    s_add_u32 s40, s38, 1
    s_and_b32 s40, s40, 7
    s_lshl_b32 s40, s40, 12
    s_add_u32 s40, s40, s37
    buffer_load_dwordx4 v8, s[12:15], s40 offen offset:0 nt lds
    buffer_load_dwordx4 v9, s[12:15], s40 offen offset:1024 nt lds
    buffer_load_dwordx4 v10, s[12:15], s40 offen offset:2048 nt lds
    buffer_load_dwordx4 v11, s[12:15], s40 offen offset:3072 nt lds
    s_add_u32 m0, m0, 0x1000
    s_barrier
    s_branch L_kwave
L_vwave:
    s_setprio 3
    v_and_b32 v0, 63, v0
    s_and_b32 s4, s2, 7
    v_lshrrev_b32 v4, 4, v0
    v_and_b32 v5, 15, v0
    s_and_b32 s41, s3, 3
    v_lshrrev_b32 v8, 3, v0
    v_and_b32 v9, 7, v0
    v_and_b32 v7, 3, v0
    v_lshlrev_b32 v2, 15, v8
    v_lshl_add_u32 v2, v9, 4, v2
    v_lshrrev_b32 v3, 2, v0
    v_lshlrev_b32 v3, 10, v3
    v_lshl_add_u32 v3, v7, 4, v3
    s_and_b32 s48, s5, 3
    s_lshr_b32 s49, s5, 2
    s_lshl_b32 s43, s4, 3
    s_add_u32 s43, s43, s49
    s_lshl_b32 s43, s43, 7
    s_lshl_b32 s39, s48, 2
    s_add_u32 s44, s39, s41
    s_lshl_b32 s39, s44, 18
    s_add_u32 s43, s43, s39
    s_lshl_b32 s44, s44, 6
    s_lshl_b32 s47, s41, 8
    s_add_u32 m0, s47, 0x1000
    s_mov_b32 s10, 0x1000
    s_mov_b32 s11, 0x20000
    s_mov_b32 s22, 0x400000
    s_mov_b32 s23, 0x20000
    v_mov_b32 v6, 0
    v_lshlrev_b32 v11, 2, v5
    ds_write_b32 v11, v6
    v_pk_mov_b32 v[84:85], -1, -1
    v_pk_mov_b32 v[86:87], -1, -1
    s_lshl_b32 s46, s4, 5
    s_add_u32 s46, s46, s5
    s_lshl_b32 s46, s46, 10
    s_add_u32 s46, s46, 0x50000
    v_lshlrev_b32 v11, 4, v0
    s_mov_b32 s34, 0x110000
    s_mov_b32 s35, 0x20000
    s_cmp_lg_u32 s3, 3
    s_waitcnt lgkmcnt(0)
    s_mov_b64 s[8:9], s[64:65]
    s_mov_b64 s[20:21], s[70:71]
    s_mov_b64 s[32:33], s[78:79]
    s_cbranch_scc1 L_v_noclr
    s_load_dword s36, s[78:79], 0
    buffer_store_dwordx4 v[84:87], v11, s[32:35], s46 offen
L_v_noclr:
    s_mov_b64 exec, 0xffff
    buffer_load_dwordx4 v3, s[8:11], s44 offen lds
    s_mov_b64 exec, -1
    buffer_load_dwordx4 v[64:67], v2, s[20:23], s43 offen nt
    s_add_u32 s43, s43, 8192
    buffer_load_dwordx4 v[68:71], v2, s[20:23], s43 offen nt
    s_add_u32 s43, s43, 8192
    buffer_load_dwordx4 v[72:75], v2, s[20:23], s43 offen nt
    s_add_u32 s43, s43, 8192
    buffer_load_dwordx4 v[76:79], v2, s[20:23], s43 offen nt
    s_barrier
    v_lshlrev_b32 v2, 4, v0
    s_mov_b64 s[16:17], s[68:69]
    s_mov_b32 s18, 0x8000000
    s_mov_b32 s19, 0x20000
    s_lshr_b32 s6, s5, 3
    s_and_b32 s7, s5, 7
    s_lshl_b32 s37, s6, 3
    s_add_u32 s37, s37, s4
    s_lshl_b32 s37, s37, 7
    s_add_u32 s37, s37, s7
    s_add_u32 s37, s37, 96
    s_lshl_b32 s37, s37, 15
    s_lshl_b32 s38, s41, 1
    s_add_u32 s38, s38, s6
    s_add_u32 s38, s38, s5
    s_add_u32 s38, s38, s2
    s_mov_b32 s55, 0x05040100
    s_mov_b32 s56, 0x07060302
    v_lshlrev_b32 v10, 6, v7
    v_lshl_add_u32 v10, v8, 3, v10
    v_add_u32 v10, s47, v10
    s_waitcnt vmcnt(4)
    ds_read_b64 v[80:81], v10 offset:4096
    s_waitcnt vmcnt(0)
    v_perm_b32 v120, v68, v64, s55
    v_perm_b32 v121, v76, v72, s55
    v_perm_b32 v122, v68, v64, s56
    v_perm_b32 v123, v76, v72, s56
    v_perm_b32 v124, v69, v65, s55
    v_perm_b32 v125, v77, v73, s55
    v_perm_b32 v126, v69, v65, s56
    v_perm_b32 v127, v77, v73, s56
    v_perm_b32 v128, v70, v66, s55
    v_perm_b32 v129, v78, v74, s55
    v_perm_b32 v130, v70, v66, s56
    v_perm_b32 v131, v78, v74, s56
    v_perm_b32 v132, v71, v67, s55
    v_perm_b32 v133, v79, v75, s55
    v_perm_b32 v134, v71, v67, s56
    v_perm_b32 v135, v79, v75, s56
    s_waitcnt lgkmcnt(0)
    v_mfma_f32_4x4x4_16b_bf16 v[88:91], v[80:81], v[120:121], 0
    v_mfma_f32_4x4x4_16b_bf16 v[92:95], v[80:81], v[122:123], 0
    v_mfma_f32_4x4x4_16b_bf16 v[96:99], v[80:81], v[124:125], 0
    v_mfma_f32_4x4x4_16b_bf16 v[100:103], v[80:81], v[126:127], 0
    v_mfma_f32_4x4x4_16b_bf16 v[104:107], v[80:81], v[128:129], 0
    v_mfma_f32_4x4x4_16b_bf16 v[108:111], v[80:81], v[130:131], 0
    v_mfma_f32_4x4x4_16b_bf16 v[112:115], v[80:81], v[132:133], 0
    v_mfma_f32_4x4x4_16b_bf16 v[116:119], v[80:81], v[134:135], 0
    s_nop 0
    v_permlane32_swap_b32 v88, v90
    v_permlane32_swap_b32 v89, v91
    v_permlane32_swap_b32 v92, v94
    v_permlane32_swap_b32 v93, v95
    v_permlane32_swap_b32 v96, v98
    v_permlane32_swap_b32 v97, v99
    v_permlane32_swap_b32 v100, v102
    v_permlane32_swap_b32 v101, v103
    v_permlane32_swap_b32 v104, v106
    v_permlane32_swap_b32 v105, v107
    v_permlane32_swap_b32 v108, v110
    v_permlane32_swap_b32 v109, v111
    v_permlane32_swap_b32 v112, v114
    v_permlane32_swap_b32 v113, v115
    v_permlane32_swap_b32 v116, v118
    v_permlane32_swap_b32 v117, v119
    v_pk_add_f32 v[88:89], v[88:89], v[90:91]
    v_pk_add_f32 v[92:93], v[92:93], v[94:95]
    v_pk_add_f32 v[96:97], v[96:97], v[98:99]
    v_pk_add_f32 v[100:101], v[100:101], v[102:103]
    v_pk_add_f32 v[104:105], v[104:105], v[106:107]
    v_pk_add_f32 v[108:109], v[108:109], v[110:111]
    v_pk_add_f32 v[112:113], v[112:113], v[114:115]
    v_pk_add_f32 v[116:117], v[116:117], v[118:119]
    v_permlane16_swap_b32 v88, v89
    v_permlane16_swap_b32 v92, v93
    v_permlane16_swap_b32 v96, v97
    v_permlane16_swap_b32 v100, v101
    v_permlane16_swap_b32 v104, v105
    v_permlane16_swap_b32 v108, v109
    v_permlane16_swap_b32 v112, v113
    v_permlane16_swap_b32 v116, v117
    v_add_f32 v88, v88, v89
    v_add_f32 v92, v92, v93
    v_add_f32 v96, v96, v97
    v_add_f32 v100, v100, v101
    v_add_f32 v104, v104, v105
    v_add_f32 v108, v108, v109
    v_add_f32 v112, v112, v113
    v_add_f32 v116, v116, v117
    v_add_f32 v16, v88, v88 row_ror:8 row_mask:0xf bank_mask:0x3
    v_add_f32 v17, v92, v92 row_ror:8 row_mask:0xf bank_mask:0x3
    v_add_f32 v18, v96, v96 row_ror:8 row_mask:0xf bank_mask:0x3
    v_add_f32 v19, v100, v100 row_ror:8 row_mask:0xf bank_mask:0x3
    v_add_f32 v16, v104, v104 row_ror:8 row_mask:0xf bank_mask:0xc
    v_add_f32 v17, v108, v108 row_ror:8 row_mask:0xf bank_mask:0xc
    v_add_f32 v18, v112, v112 row_ror:8 row_mask:0xf bank_mask:0xc
    v_add_f32 v19, v116, v116 row_ror:8 row_mask:0xf bank_mask:0xc
    s_cmp_eq_u32 s3, 3
    s_cbranch_scc1 L_qwave
    s_lshl_b32 s39, s41, 10
    v_add_u32 v10, s39, v2
    v_mov_b32 v12, 1
    ds_write_b128 v10, v[16:19] offset:8192
    s_mov_b64 exec, 1
    ds_add_u32 v6, v12 offset:12
    s_mov_b64 exec, -1
    s_branch L_v_go
L_qwave:
    s_add_u32 s36, s36, 0x9e3779b1
    s_getreg_b32 s45, hwreg(HW_REG_XCC_ID)
    s_and_b32 s45, s45, 15
    s_and_b32 s46, s36, 0xfffffff0
    s_or_b32 s46, s46, s45
    s_bfe_u32 s60, s46, 0x80000
    s_bfe_u32 s61, s46, 0x80008
    s_bfe_u32 s62, s46, 0x80010
    s_bfe_u32 s63, s46, 0x80018
    s_mov_b32 s59, 0xffffff00
    v_lshlrev_b32 v10, 13, v4
    v_lshl_add_u32 v10, v5, 4, v10
    s_lshl_b32 s43, s4, 15
    s_add_u32 s43, s43, 0x1000
    s_lshl_b32 s39, s48, 11
    s_add_u32 s44, s43, s39
    s_lshl_b32 s39, s49, 8
    s_add_u32 s44, s44, s39
    s_mov_b32 s54, 800000
L_lp1:
    ds_read_b32 v3, v6 offset:12
    s_waitcnt lgkmcnt(0)
    v_readfirstlane_b32 s39, v3
    s_cmp_eq_u32 s39, 3
    s_cbranch_scc1 L_ld1
    s_sub_u32 s54, s54, 1
    s_cbranch_scc0 L_lp1
L_ld1:
    ds_read_b128 v[20:23], v2 offset:8192
    ds_read_b128 v[24:27], v2 offset:9216
    ds_read_b128 v[28:31], v2 offset:10240
    s_waitcnt lgkmcnt(2)
    v_pk_add_f32 v[16:17], v[16:17], v[20:21]
    v_pk_add_f32 v[18:19], v[18:19], v[22:23]
    s_waitcnt lgkmcnt(0)
    v_pk_add_f32 v[24:25], v[24:25], v[28:29]
    v_pk_add_f32 v[26:27], v[26:27], v[30:31]
    v_pk_add_f32 v[16:17], v[16:17], v[24:25]
    v_pk_add_f32 v[18:19], v[18:19], v[26:27]
    v_and_b32 v16, s59, v16
    v_and_b32 v17, s59, v17
    v_and_b32 v18, s59, v18
    v_and_b32 v19, s59, v19
    v_or_b32 v16, s60, v16
    v_or_b32 v17, s61, v17
    v_or_b32 v18, s62, v18
    v_or_b32 v19, s63, v19
    buffer_store_dwordx4 v[16:19], v10, s[32:35], s44 offen
    s_nop 0
L_v_go:
    s_setprio 0
    v_pk_mov_b32 v[200:201], 0, 0
    v_pk_mov_b32 v[202:203], 0, 0
    v_pk_mov_b32 v[204:205], 0, 0
    v_pk_mov_b32 v[206:207], 0, 0
    v_pk_mov_b32 v[208:209], 0, 0
    v_pk_mov_b32 v[210:211], 0, 0
    v_pk_mov_b32 v[212:213], 0, 0
    v_pk_mov_b32 v[214:215], 0, 0
    v_pk_mov_b32 v[48:49], 0, 0
    v_pk_mov_b32 v[50:51], 0, 0
    v_pk_mov_b32 v[52:53], 0, 0
    v_pk_mov_b32 v[54:55], 0, 0
    v_pk_mov_b32 v[56:57], 0, 0
    v_pk_mov_b32 v[58:59], 0, 0
    v_pk_mov_b32 v[60:61], 0, 0
    v_pk_mov_b32 v[62:63], 0, 0
    v_pk_mov_b32 v[32:33], 0, 0
    v_pk_mov_b32 v[34:35], 0, 0
    v_pk_mov_b32 v[36:37], 0, 0
    v_pk_mov_b32 v[38:39], 0, 0
    v_pk_mov_b32 v[40:41], 0, 0
    v_pk_mov_b32 v[42:43], 0, 0
    v_pk_mov_b32 v[44:45], 0, 0
    v_pk_mov_b32 v[46:47], 0, 0
    v_pk_mov_b32 v[16:17], 0, 0
    v_pk_mov_b32 v[18:19], 0, 0
    v_pk_mov_b32 v[20:21], 0, 0
    v_pk_mov_b32 v[22:23], 0, 0
    v_pk_mov_b32 v[24:25], 0, 0
    v_pk_mov_b32 v[26:27], 0, 0
    v_pk_mov_b32 v[28:29], 0, 0
    v_pk_mov_b32 v[30:31], 0, 0
    v_mov_b32 v12, 1
    s_lshl_b32 s39, s41, 2
    v_mov_b32 v8, s39
    s_lshl_b32 s39, s41, 15
    v_add_u32 v13, s39, v2
    s_lshl_b32 s39, s41, 11
    v_add_u32 v9, s39, v2
    v_lshlrev_b32 v10, 13, v7
    v_lshl_add_u32 v10, v4, 11, v10
    v_lshrrev_b32 v3, 2, v5
    v_lshl_add_u32 v10, v3, 8, v10
    s_lshl_b32 s42, s4, 15
    s_lshr_b32 s39, s7, 2
    s_lshl_b32 s39, s39, 10
    s_add_u32 s42, s42, s39
    s_and_b32 s39, s7, 3
    s_lshl_b32 s39, s39, 4
    s_add_u32 s42, s42, s39
    s_lshl_b32 s39, s6, 6
    s_add_u32 s42, s42, s39
    s_add_u32 s42, s42, 0x50000
    s_mov_b32 s54, 800000
L_lp2:
    ds_read_b32 v3, v6 offset:36
    s_waitcnt lgkmcnt(0)
    v_readfirstlane_b32 s39, v3
    s_cmp_eq_u32 s39, 4
    s_cbranch_scc1 L_ld2
    s_sleep 1
    s_sub_u32 s54, s54, 1
    s_cbranch_scc0 L_lp2
L_ld2:
    s_and_b32 s39, s2, 1
    s_xor_b32 s39, s39, 1
    s_mov_b32 vcc_lo, s39
    s_mov_b32 vcc_hi, 0
    s_and_b32 s40, s38, 7
    s_lshl_b32 s40, s40, 12
    s_add_u32 s40, s40, s37
    buffer_load_dwordx4 v[64:67], v2, s[16:19], s40 offen offset:0 nt
    buffer_load_dwordx4 v[68:71], v2, s[16:19], s40 offen offset:1024 nt
    buffer_load_dwordx4 v[72:75], v2, s[16:19], s40 offen offset:2048 nt
    buffer_load_dwordx4 v[76:79], v2, s[16:19], s40 offen offset:3072 nt
    s_add_u32 s40, s38, 1
    s_and_b32 s40, s40, 7
    s_lshl_b32 s40, s40, 12
    s_add_u32 s40, s40, s37
    buffer_load_dwordx4 v[80:83], v2, s[16:19], s40 offen offset:0 nt
    buffer_load_dwordx4 v[84:87], v2, s[16:19], s40 offen offset:1024 nt
    buffer_load_dwordx4 v[88:91], v2, s[16:19], s40 offen offset:2048 nt
    buffer_load_dwordx4 v[92:95], v2, s[16:19], s40 offen offset:3072 nt
    s_add_u32 s40, s38, 2
    s_and_b32 s40, s40, 7
    s_lshl_b32 s40, s40, 12
    s_add_u32 s40, s40, s37
    s_add_u32 s40, s40, 0x40000
    buffer_load_dwordx4 v[96:99], v2, s[16:19], s40 offen offset:0 nt
    s_cbranch_vccz L_w3
    s_waitcnt vmcnt(8)
L_w3:
    buffer_load_dwordx4 v[100:103], v2, s[16:19], s40 offen offset:1024 nt
    s_cbranch_vccz L_w4
    s_waitcnt vmcnt(8)
L_w4:
    buffer_load_dwordx4 v[104:107], v2, s[16:19], s40 offen offset:2048 nt
    s_cbranch_vccz L_w5
    s_waitcnt vmcnt(8)
L_w5:
    buffer_load_dwordx4 v[108:111], v2, s[16:19], s40 offen offset:3072 nt
    s_add_u32 s40, s38, 3
    s_and_b32 s40, s40, 7
    s_lshl_b32 s40, s40, 12
    s_add_u32 s40, s40, s37
    s_add_u32 s40, s40, 0x40000
    s_cbranch_vccz L_w6
    s_waitcnt vmcnt(8)
L_w6:
    buffer_load_dwordx4 v[112:115], v2, s[16:19], s40 offen offset:0 nt
    s_cbranch_vccz L_w7
    s_waitcnt vmcnt(8)
L_w7:
    buffer_load_dwordx4 v[116:119], v2, s[16:19], s40 offen offset:1024 nt
    s_cbranch_vccz L_w8
    s_waitcnt vmcnt(8)
L_w8:
    buffer_load_dwordx4 v[120:123], v2, s[16:19], s40 offen offset:2048 nt
    s_cbranch_vccz L_w9
    s_waitcnt vmcnt(8)
L_w9:
    buffer_load_dwordx4 v[124:127], v2, s[16:19], s40 offen offset:3072 nt
    s_add_u32 s40, s38, 4
    s_and_b32 s40, s40, 7
    s_lshl_b32 s40, s40, 12
    s_add_u32 s40, s40, s37
    s_add_u32 s40, s40, 0x80000
    s_cbranch_vccz L_w10
    s_waitcnt vmcnt(8)
L_w10:
    buffer_load_dwordx4 v[128:131], v2, s[16:19], s40 offen offset:0 nt
    s_cbranch_vccz L_w11
    s_waitcnt vmcnt(8)
L_w11:
    buffer_load_dwordx4 v[132:135], v2, s[16:19], s40 offen offset:1024 nt
    s_cbranch_vccz L_w12
    s_waitcnt vmcnt(8)
L_w12:
    buffer_load_dwordx4 v[136:139], v2, s[16:19], s40 offen offset:2048 nt
    s_cbranch_vccz L_w13
    s_waitcnt vmcnt(8)
L_w13:
    buffer_load_dwordx4 v[140:143], v2, s[16:19], s40 offen offset:3072 nt
    s_add_u32 s40, s38, 5
    s_and_b32 s40, s40, 7
    s_lshl_b32 s40, s40, 12
    s_add_u32 s40, s40, s37
    s_add_u32 s40, s40, 0x80000
    s_cbranch_vccz L_w14
    s_waitcnt vmcnt(8)
L_w14:
    s_waitcnt vmcnt(19)
    buffer_load_dwordx4 v[144:147], v2, s[16:19], s40 offen offset:0 nt
    s_cbranch_vccz L_w15
    s_waitcnt vmcnt(8)
L_w15:
    s_waitcnt vmcnt(19)
    buffer_load_dwordx4 v[148:151], v2, s[16:19], s40 offen offset:1024 nt
    s_cbranch_vccz L_w16
    s_waitcnt vmcnt(8)
L_w16:
    s_waitcnt vmcnt(19)
    buffer_load_dwordx4 v[152:155], v2, s[16:19], s40 offen offset:2048 nt
    s_cbranch_vccz L_w17
    s_waitcnt vmcnt(8)
L_w17:
    s_waitcnt vmcnt(19)
    buffer_load_dwordx4 v[156:159], v2, s[16:19], s40 offen offset:3072 nt
    s_add_u32 s40, s38, 6
    s_and_b32 s40, s40, 7
    s_lshl_b32 s40, s40, 12
    s_add_u32 s40, s40, s37
    s_add_u32 s40, s40, 0xc0000
    s_cbranch_vccz L_w18
    s_waitcnt vmcnt(8)
L_w18:
    s_waitcnt vmcnt(19)
    buffer_load_dwordx4 v[160:163], v2, s[16:19], s40 offen offset:0 nt
    s_cbranch_vccz L_w19
    s_waitcnt vmcnt(8)
L_w19:
    s_waitcnt vmcnt(19)
    buffer_load_dwordx4 v[164:167], v2, s[16:19], s40 offen offset:1024 nt
    s_cbranch_vccz L_w20
    s_waitcnt vmcnt(8)
L_w20:
    s_waitcnt vmcnt(19)
    buffer_load_dwordx4 v[168:171], v2, s[16:19], s40 offen offset:2048 nt
    s_cbranch_vccz L_w21
    s_waitcnt vmcnt(8)
L_w21:
    s_waitcnt vmcnt(19)
    buffer_load_dwordx4 v[172:175], v2, s[16:19], s40 offen offset:3072 nt
    s_mov_b32 s54, 800000
L_lp22:
    ds_read_b32 v3, v8 offset:16
    s_waitcnt lgkmcnt(0)
    v_readfirstlane_b32 s39, v3
    s_cmp_eq_u32 s39, 1
    s_cbranch_scc1 L_ld22
    s_sleep 1
    s_sub_u32 s54, s54, 1
    s_cbranch_scc0 L_lp22
L_ld22:
    s_setprio 2
    s_mov_b32 exec_lo, 0xf000f
    s_mov_b32 exec_hi, 0xf000f
    ds_read_b128 v[16:19], v13 offset:16384
    ds_read_b128 v[32:35], v13 offset:17408
    ds_read_b128 v[48:51], v13 offset:18432
    ds_read_b128 v[200:203], v13 offset:19456
    s_mov_b32 exec_lo, 0xf000f0
    s_mov_b32 exec_hi, 0xf000f0
    ds_read_b128 v[20:23], v13 offset:16384
    ds_read_b128 v[36:39], v13 offset:17408
    ds_read_b128 v[52:55], v13 offset:18432
    ds_read_b128 v[204:207], v13 offset:19456
    s_mov_b32 exec_lo, 0xf000f00
    s_mov_b32 exec_hi, 0xf000f00
    ds_read_b128 v[24:27], v13 offset:16384
    ds_read_b128 v[40:43], v13 offset:17408
    ds_read_b128 v[56:59], v13 offset:18432
    ds_read_b128 v[208:211], v13 offset:19456
    s_mov_b32 exec_lo, 0xf000f000
    s_mov_b32 exec_hi, 0xf000f000
    ds_read_b128 v[28:31], v13 offset:16384
    ds_read_b128 v[44:47], v13 offset:17408
    ds_read_b128 v[60:63], v13 offset:18432
    ds_read_b128 v[212:215], v13 offset:19456
    s_mov_b64 exec, -1
    ds_read_b32 v11, v6 offset:40
    s_waitcnt vmcnt(26)
    v_perm_b32 v224, v68, v64, s55
    v_perm_b32 v228, v68, v64, s56
    v_perm_b32 v232, v69, v65, s55
    v_perm_b32 v236, v69, v65, s56
    v_perm_b32 v240, v70, v66, s55
    v_perm_b32 v244, v70, v66, s56
    v_perm_b32 v248, v71, v67, s55
    v_perm_b32 v252, v71, v67, s56
    s_waitcnt vmcnt(24)
    v_perm_b32 v225, v76, v72, s55
    v_perm_b32 v229, v76, v72, s56
    v_perm_b32 v233, v77, v73, s55
    v_perm_b32 v237, v77, v73, s56
    v_perm_b32 v241, v78, v74, s55
    v_perm_b32 v245, v78, v74, s56
    v_perm_b32 v249, v79, v75, s55
    v_perm_b32 v253, v79, v75, s56
    s_waitcnt vmcnt(22)
    v_perm_b32 v226, v84, v80, s55
    v_perm_b32 v230, v84, v80, s56
    v_perm_b32 v234, v85, v81, s55
    v_perm_b32 v238, v85, v81, s56
    v_perm_b32 v242, v86, v82, s55
    v_perm_b32 v246, v86, v82, s56
    v_perm_b32 v250, v87, v83, s55
    v_perm_b32 v254, v87, v83, s56
    s_waitcnt vmcnt(20)
    s_waitcnt lgkmcnt(0)
    v_readfirstlane_b32 s47, v11
    v_perm_b32 v227, v92, v88, s55
    v_perm_b32 v231, v92, v88, s56
    v_perm_b32 v235, v93, v89, s55
    v_mfma_f32_16x16x32_bf16 v[192:195], v[224:227], v[16:19], 0
    v_perm_b32 v239, v93, v89, s56
    v_mfma_f32_16x16x32_bf16 v[196:199], v[228:231], v[16:19], 0
    v_perm_b32 v243, v94, v90, s55
    v_mfma_f32_16x16x32_bf16 v[192:195], v[232:235], v[20:23], v[192:195]
    v_perm_b32 v247, v94, v90, s56
    v_mfma_f32_16x16x32_bf16 v[196:199], v[236:239], v[20:23], v[196:199]
    v_perm_b32 v251, v95, v91, s55
    v_mfma_f32_16x16x32_bf16 v[192:195], v[240:243], v[24:27], v[192:195]
    v_perm_b32 v255, v95, v91, s56
    v_mfma_f32_16x16x32_bf16 v[196:199], v[244:247], v[24:27], v[196:199]
    v_mfma_f32_16x16x32_bf16 v[192:195], v[248:251], v[28:31], v[192:195]
    v_mfma_f32_16x16x32_bf16 v[196:199], v[252:255], v[28:31], v[196:199]
    s_add_u32 s40, s38, 7
    s_and_b32 s40, s40, 7
    s_lshl_b32 s40, s40, 12
    s_add_u32 s40, s40, s37
    s_add_u32 s40, s40, 0xc0000
    s_cbranch_vccz L_w23
    s_waitcnt vmcnt(8)
L_w23:
    s_waitcnt vmcnt(19)
    buffer_load_dwordx4 v[176:179], v2, s[16:19], s40 offen offset:0 nt
    s_cbranch_vccz L_w24
    s_waitcnt vmcnt(8)
L_w24:
    s_waitcnt vmcnt(19)
    buffer_load_dwordx4 v[180:183], v2, s[16:19], s40 offen offset:1024 nt
    s_cbranch_vccz L_w25
    s_waitcnt vmcnt(8)
L_w25:
    s_waitcnt vmcnt(19)
    buffer_load_dwordx4 v[184:187], v2, s[16:19], s40 offen offset:2048 nt
    s_cbranch_vccz L_w26
    s_waitcnt vmcnt(8)
L_w26:
    s_waitcnt vmcnt(19)
    buffer_load_dwordx4 v[188:191], v2, s[16:19], s40 offen offset:3072 nt
    s_mov_b64 exec, 1
    ds_add_u32 v6, v12 offset:32
    s_mov_b64 exec, -1
    s_waitcnt vmcnt(22)
    v_perm_b32 v224, v100, v96, s55
    v_perm_b32 v228, v100, v96, s56
    v_perm_b32 v232, v101, v97, s55
    v_perm_b32 v236, v101, v97, s56
    v_perm_b32 v240, v102, v98, s55
    v_perm_b32 v244, v102, v98, s56
    v_perm_b32 v248, v103, v99, s55
    v_perm_b32 v252, v103, v99, s56
    s_waitcnt vmcnt(20)
    v_perm_b32 v225, v108, v104, s55
    v_perm_b32 v229, v108, v104, s56
    v_perm_b32 v233, v109, v105, s55
    v_perm_b32 v237, v109, v105, s56
    v_perm_b32 v241, v110, v106, s55
    v_perm_b32 v245, v110, v106, s56
    v_perm_b32 v249, v111, v107, s55
    v_perm_b32 v253, v111, v107, s56
    s_waitcnt vmcnt(18)
    v_perm_b32 v226, v116, v112, s55
    v_perm_b32 v230, v116, v112, s56
    v_perm_b32 v234, v117, v113, s55
    v_perm_b32 v238, v117, v113, s56
    v_perm_b32 v242, v118, v114, s55
    v_perm_b32 v246, v118, v114, s56
    v_perm_b32 v250, v119, v115, s55
    v_perm_b32 v254, v119, v115, s56
    s_waitcnt vmcnt(16)
    v_perm_b32 v227, v124, v120, s55
    v_perm_b32 v231, v124, v120, s56
    v_perm_b32 v235, v125, v121, s55
    v_mfma_f32_16x16x32_bf16 v[192:195], v[224:227], v[32:35], v[192:195]
    v_perm_b32 v239, v125, v121, s56
    v_mfma_f32_16x16x32_bf16 v[196:199], v[228:231], v[32:35], v[196:199]
    v_perm_b32 v243, v126, v122, s55
    v_mfma_f32_16x16x32_bf16 v[192:195], v[232:235], v[36:39], v[192:195]
    v_perm_b32 v247, v126, v122, s56
    v_mfma_f32_16x16x32_bf16 v[196:199], v[236:239], v[36:39], v[196:199]
    v_perm_b32 v251, v127, v123, s55
    v_mfma_f32_16x16x32_bf16 v[192:195], v[240:243], v[40:43], v[192:195]
    v_perm_b32 v255, v127, v123, s56
    v_mfma_f32_16x16x32_bf16 v[196:199], v[244:247], v[40:43], v[196:199]
    v_mfma_f32_16x16x32_bf16 v[192:195], v[248:251], v[44:47], v[192:195]
    v_mfma_f32_16x16x32_bf16 v[196:199], v[252:255], v[44:47], v[196:199]
    s_waitcnt vmcnt(14)
    v_perm_b32 v224, v132, v128, s55
    v_perm_b32 v228, v132, v128, s56
    v_perm_b32 v232, v133, v129, s55
    v_perm_b32 v236, v133, v129, s56
    v_perm_b32 v240, v134, v130, s55
    v_perm_b32 v244, v134, v130, s56
    v_perm_b32 v248, v135, v131, s55
    v_perm_b32 v252, v135, v131, s56
    s_waitcnt vmcnt(12)
    v_perm_b32 v225, v140, v136, s55
    v_perm_b32 v229, v140, v136, s56
    v_perm_b32 v233, v141, v137, s55
    v_perm_b32 v237, v141, v137, s56
    v_perm_b32 v241, v142, v138, s55
    v_perm_b32 v245, v142, v138, s56
    v_perm_b32 v249, v143, v139, s55
    v_perm_b32 v253, v143, v139, s56
    s_waitcnt vmcnt(10)
    v_perm_b32 v226, v148, v144, s55
    v_perm_b32 v230, v148, v144, s56
    v_perm_b32 v234, v149, v145, s55
    v_perm_b32 v238, v149, v145, s56
    v_perm_b32 v242, v150, v146, s55
    v_perm_b32 v246, v150, v146, s56
    v_perm_b32 v250, v151, v147, s55
    v_perm_b32 v254, v151, v147, s56
    s_waitcnt vmcnt(8)
    v_perm_b32 v227, v156, v152, s55
    v_perm_b32 v231, v156, v152, s56
    v_perm_b32 v235, v157, v153, s55
    v_mfma_f32_16x16x32_bf16 v[192:195], v[224:227], v[48:51], v[192:195]
    v_perm_b32 v239, v157, v153, s56
    v_mfma_f32_16x16x32_bf16 v[196:199], v[228:231], v[48:51], v[196:199]
    v_perm_b32 v243, v158, v154, s55
    v_mfma_f32_16x16x32_bf16 v[192:195], v[232:235], v[52:55], v[192:195]
    v_perm_b32 v247, v158, v154, s56
    v_mfma_f32_16x16x32_bf16 v[196:199], v[236:239], v[52:55], v[196:199]
    v_perm_b32 v251, v159, v155, s55
    v_mfma_f32_16x16x32_bf16 v[192:195], v[240:243], v[56:59], v[192:195]
    v_perm_b32 v255, v159, v155, s56
    v_mfma_f32_16x16x32_bf16 v[196:199], v[244:247], v[56:59], v[196:199]
    v_mfma_f32_16x16x32_bf16 v[192:195], v[248:251], v[60:63], v[192:195]
    v_mfma_f32_16x16x32_bf16 v[196:199], v[252:255], v[60:63], v[196:199]
    s_waitcnt vmcnt(6)
    v_perm_b32 v224, v164, v160, s55
    v_perm_b32 v228, v164, v160, s56
    v_perm_b32 v232, v165, v161, s55
    v_perm_b32 v236, v165, v161, s56
    v_perm_b32 v240, v166, v162, s55
    v_perm_b32 v244, v166, v162, s56
    v_perm_b32 v248, v167, v163, s55
    v_perm_b32 v252, v167, v163, s56
    s_waitcnt vmcnt(4)
    v_perm_b32 v225, v172, v168, s55
    v_perm_b32 v229, v172, v168, s56
    v_perm_b32 v233, v173, v169, s55
    v_perm_b32 v237, v173, v169, s56
    v_perm_b32 v241, v174, v170, s55
    v_perm_b32 v245, v174, v170, s56
    v_perm_b32 v249, v175, v171, s55
    v_perm_b32 v253, v175, v171, s56
    s_waitcnt vmcnt(2)
    v_perm_b32 v226, v180, v176, s55
    v_perm_b32 v230, v180, v176, s56
    v_perm_b32 v234, v181, v177, s55
    v_perm_b32 v238, v181, v177, s56
    v_perm_b32 v242, v182, v178, s55
    v_perm_b32 v246, v182, v178, s56
    v_perm_b32 v250, v183, v179, s55
    v_perm_b32 v254, v183, v179, s56
    s_waitcnt vmcnt(0)
    v_perm_b32 v227, v188, v184, s55
    v_perm_b32 v231, v188, v184, s56
    v_perm_b32 v235, v189, v185, s55
    v_mfma_f32_16x16x32_bf16 v[192:195], v[224:227], v[200:203], v[192:195]
    v_perm_b32 v239, v189, v185, s56
    v_mfma_f32_16x16x32_bf16 v[196:199], v[228:231], v[200:203], v[196:199]
    v_perm_b32 v243, v190, v186, s55
    v_mfma_f32_16x16x32_bf16 v[192:195], v[232:235], v[204:207], v[192:195]
    v_perm_b32 v247, v190, v186, s56
    v_mfma_f32_16x16x32_bf16 v[196:199], v[236:239], v[204:207], v[196:199]
    v_perm_b32 v251, v191, v187, s55
    v_mfma_f32_16x16x32_bf16 v[192:195], v[240:243], v[208:211], v[192:195]
    v_perm_b32 v255, v191, v187, s56
    v_mfma_f32_16x16x32_bf16 v[196:199], v[244:247], v[208:211], v[196:199]
    v_mfma_f32_16x16x32_bf16 v[192:195], v[248:251], v[212:215], v[192:195]
    v_mfma_f32_16x16x32_bf16 v[196:199], v[252:255], v[212:215], v[196:199]
    s_nop 6
    ds_write_b128 v9, v[192:195] offset:8192
    ds_write_b128 v9, v[196:199] offset:9216
    s_mov_b64 exec, 1
    ds_add_rtn_u32 v3, v6, v12 offset:44
    s_mov_b64 exec, -1
    ds_read_b128 v[16:19], v2 offset:8192
    ds_read_b128 v[20:23], v2 offset:9216
    ds_read_b128 v[24:27], v2 offset:10240
    ds_read_b128 v[28:31], v2 offset:11264
    ds_read_b128 v[32:35], v2 offset:12288
    ds_read_b128 v[36:39], v2 offset:13312
    ds_read_b128 v[40:43], v2 offset:14336
    ds_read_b128 v[44:47], v2 offset:15360
    s_waitcnt lgkmcnt(8)
    v_readfirstlane_b32 s39, v3
    s_cmp_lg_u32 s39, 3
    s_cbranch_scc1 L_fin
    s_waitcnt lgkmcnt(4)
    v_pk_add_f32 v[16:17], v[16:17], v[24:25]
    v_pk_add_f32 v[18:19], v[18:19], v[26:27]
    v_pk_add_f32 v[20:21], v[20:21], v[28:29]
    v_pk_add_f32 v[22:23], v[22:23], v[30:31]
    s_waitcnt lgkmcnt(0)
    v_pk_add_f32 v[32:33], v[32:33], v[40:41]
    v_pk_add_f32 v[34:35], v[34:35], v[42:43]
    v_pk_add_f32 v[36:37], v[36:37], v[44:45]
    v_pk_add_f32 v[38:39], v[38:39], v[46:47]
    v_pk_add_f32 v[192:193], v[16:17], v[32:33]
    v_pk_add_f32 v[194:195], v[18:19], v[34:35]
    v_pk_add_f32 v[196:197], v[20:21], v[36:37]
    v_pk_add_f32 v[198:199], v[22:23], v[38:39]
    v_cvt_pk_bf16_f32 v40, v192, v193
    v_cvt_pk_bf16_f32 v41, v194, v195
    v_cvt_pk_bf16_f32 v42, v196, v197
    v_cvt_pk_bf16_f32 v43, v198, v199
    s_cmp_eq_u32 s47, 0
    s_cbranch_scc0 L_v_slow
    buffer_store_dwordx4 v[40:43], v10, s[32:35], s42 offen
    s_branch L_fin
L_v_slow:
    s_load_dword s36, s[78:79], 0
    s_add_u32 s42, s42, 0x80000
    buffer_store_dwordx4 v[40:43], v10, s[32:35], s42 offen sc1
    s_lshl_b32 s42, s4, 5
    s_add_u32 s42, s42, s5
    s_lshl_b32 s42, s42, 2
    s_add_u32 s42, s42, 0x48000
    s_waitcnt vmcnt(0) lgkmcnt(0)
    s_add_u32 s36, s36, 0x9e3779b1
    v_mov_b32 v44, s36
    s_mov_b64 exec, 1
    buffer_store_dword v44, v6, s[32:35], s42 offen sc1
    s_branch L_fin
L_kwave:
    v_mov_b32 v12, 1
    v_mov_b32 v6, 0
    s_and_b32 s39, s2, 1
    s_xor_b32 s39, s39, 1
    s_mov_b32 vcc_lo, s39
    s_mov_b32 vcc_hi, 0
    s_add_u32 s40, s38, 2
    s_and_b32 s40, s40, 7
    s_lshl_b32 s40, s40, 12
    s_add_u32 s40, s40, s37
    s_add_u32 s40, s40, 0x40000
    buffer_load_dwordx4 v8, s[12:15], s40 offen offset:0 nt lds
    s_cbranch_vccz L_w27
    s_waitcnt vmcnt(8)
L_w27:
    buffer_load_dwordx4 v9, s[12:15], s40 offen offset:1024 nt lds
    s_cbranch_vccz L_w28
    s_waitcnt vmcnt(8)
L_w28:
    buffer_load_dwordx4 v10, s[12:15], s40 offen offset:2048 nt lds
    s_cbranch_vccz L_w29
    s_waitcnt vmcnt(8)
L_w29:
    buffer_load_dwordx4 v11, s[12:15], s40 offen offset:3072 nt lds
    s_add_u32 m0, m0, 0x1000
    s_add_u32 s40, s38, 3
    s_and_b32 s40, s40, 7
    s_lshl_b32 s40, s40, 12
    s_add_u32 s40, s40, s37
    s_add_u32 s40, s40, 0x40000
    s_cbranch_vccz L_w30
    s_waitcnt vmcnt(8)
L_w30:
    buffer_load_dwordx4 v8, s[12:15], s40 offen offset:0 nt lds
    s_cbranch_vccz L_w31
    s_waitcnt vmcnt(8)
L_w31:
    buffer_load_dwordx4 v9, s[12:15], s40 offen offset:1024 nt lds
    s_cbranch_vccz L_w32
    s_waitcnt vmcnt(8)
L_w32:
    buffer_load_dwordx4 v10, s[12:15], s40 offen offset:2048 nt lds
    s_cbranch_vccz L_w33
    s_waitcnt vmcnt(8)
L_w33:
    buffer_load_dwordx4 v11, s[12:15], s40 offen offset:3072 nt lds
    s_add_u32 m0, m0, 0x1000
    s_add_u32 s40, s38, 4
    s_and_b32 s40, s40, 7
    s_lshl_b32 s40, s40, 12
    s_add_u32 s40, s40, s37
    s_add_u32 s40, s40, 0x80000
    s_cbranch_vccz L_w34
    s_waitcnt vmcnt(8)
L_w34:
    buffer_load_dwordx4 v8, s[12:15], s40 offen offset:0 nt lds
    s_cbranch_vccz L_w35
    s_waitcnt vmcnt(8)
L_w35:
    buffer_load_dwordx4 v9, s[12:15], s40 offen offset:1024 nt lds
    s_cbranch_vccz L_w36
    s_waitcnt vmcnt(8)
L_w36:
    buffer_load_dwordx4 v10, s[12:15], s40 offen offset:2048 nt lds
    s_cbranch_vccz L_w37
    s_waitcnt vmcnt(8)
L_w37:
    buffer_load_dwordx4 v11, s[12:15], s40 offen offset:3072 nt lds
    s_add_u32 m0, m0, 0x1000
    s_add_u32 s40, s38, 5
    s_and_b32 s40, s40, 7
    s_lshl_b32 s40, s40, 12
    s_add_u32 s40, s40, s37
    s_add_u32 s40, s40, 0x80000
    s_cbranch_vccz L_w38
    s_waitcnt vmcnt(8)
L_w38:
    s_waitcnt vmcnt(19)
    buffer_load_dwordx4 v8, s[12:15], s40 offen offset:0 nt lds
    s_cbranch_vccz L_w39
    s_waitcnt vmcnt(8)
L_w39:
    s_waitcnt vmcnt(19)
    buffer_load_dwordx4 v9, s[12:15], s40 offen offset:1024 nt lds
    s_cbranch_vccz L_w40
    s_waitcnt vmcnt(8)
L_w40:
    s_waitcnt vmcnt(19)
    buffer_load_dwordx4 v10, s[12:15], s40 offen offset:2048 nt lds
    s_cbranch_vccz L_w41
    s_waitcnt vmcnt(8)
L_w41:
    s_waitcnt vmcnt(19)
    buffer_load_dwordx4 v11, s[12:15], s40 offen offset:3072 nt lds
    s_add_u32 m0, m0, 0x1000
    s_add_u32 s40, s38, 6
    s_and_b32 s40, s40, 7
    s_lshl_b32 s40, s40, 12
    s_add_u32 s40, s40, s37
    s_add_u32 s40, s40, 0xc0000
    s_cbranch_vccz L_w42
    s_waitcnt vmcnt(8)
L_w42:
    s_waitcnt vmcnt(19)
    buffer_load_dwordx4 v8, s[12:15], s40 offen offset:0 nt lds
    s_cbranch_vccz L_w43
    s_waitcnt vmcnt(8)
L_w43:
    s_waitcnt vmcnt(19)
    buffer_load_dwordx4 v9, s[12:15], s40 offen offset:1024 nt lds
    s_cbranch_vccz L_w44
    s_waitcnt vmcnt(8)
L_w44:
    s_waitcnt vmcnt(19)
    buffer_load_dwordx4 v10, s[12:15], s40 offen offset:2048 nt lds
    s_cbranch_vccz L_w45
    s_waitcnt vmcnt(8)
L_w45:
    s_waitcnt vmcnt(19)
    buffer_load_dwordx4 v11, s[12:15], s40 offen offset:3072 nt lds
    s_add_u32 m0, m0, 0x1000
    s_add_u32 s40, s38, 7
    s_and_b32 s40, s40, 7
    s_lshl_b32 s40, s40, 12
    s_add_u32 s40, s40, s37
    s_add_u32 s40, s40, 0xc0000
    s_cbranch_vccz L_w46
    s_waitcnt vmcnt(8)
L_w46:
    s_waitcnt vmcnt(19)
    buffer_load_dwordx4 v8, s[12:15], s40 offen offset:0 nt lds
    s_cbranch_vccz L_w47
    s_waitcnt vmcnt(8)
L_w47:
    s_waitcnt vmcnt(19)
    buffer_load_dwordx4 v9, s[12:15], s40 offen offset:1024 nt lds
    s_cbranch_vccz L_w48
    s_waitcnt vmcnt(8)
L_w48:
    s_waitcnt vmcnt(19)
    buffer_load_dwordx4 v10, s[12:15], s40 offen offset:2048 nt lds
    s_cbranch_vccz L_w49
    s_waitcnt vmcnt(8)
L_w49:
    s_waitcnt vmcnt(19)
    buffer_load_dwordx4 v11, s[12:15], s40 offen offset:3072 nt lds
    s_lshl_b32 s48, s4, 15
    s_lshl_b32 s39, s6, 13
    s_add_u32 s48, s48, s39
    s_lshl_b32 s39, s41, 9
    s_add_u32 s48, s48, s39
    s_add_u32 s48, s48, 0x1000
    v_lshrrev_b32 v13, 5, v0
    v_lshlrev_b32 v13, 12, v13
    v_and_b32 v14, 31, v0
    v_lshl_add_u32 v13, v14, 4, v13
    s_mov_b32 s34, 0x110000
    s_mov_b32 s35, 0x20000
    s_mov_b64 s[32:33], s[78:79]
    buffer_load_dwordx4 v[20:23], v13, s[32:35], s48 offen sc1
    buffer_load_dwordx4 v[24:27], v13, s[32:35], s48 offen offset:2048 sc1
    v_mov_b32 v12, 1
    v_mov_b32 v6, 0
    v_and_b32 v7, 3, v0
    s_mov_b64 exec, 1
    ds_add_u32 v6, v12 offset:36
    s_mov_b64 exec, -1
    s_load_dword s36, s[78:79], 0
    s_mov_b64 s[24:25], s[72:73]
    s_mov_b64 s[28:29], s[74:75]
    s_mov_b32 s26, 0x400000
    s_mov_b32 s27, 0x20000
    s_mov_b32 s30, 0x1000
    s_mov_b32 s31, 0x20000
    s_mov_b32 s55, 0x05040100
    s_mov_b32 s56, 0x07060302
    s_setprio 0
    v_lshlrev_b32 v2, 2, v7
    v_lshrrev_b32 v3, 2, v5
    v_add_u32 v2, v2, v3
    v_lshlrev_b32 v2, 8, v2
    v_add_u32 v2, s45, v2
    v_xor_b32 v3, v4, v5
    v_xor_b32 v8, 0, v3
    v_lshl_add_u32 v8, v8, 4, v2
    v_xor_b32 v9, 4, v3
    v_lshl_add_u32 v9, v9, 4, v2
    v_xor_b32 v10, 8, v3
    v_lshl_add_u32 v10, v10, 4, v2
    v_xor_b32 v11, 12, v3
    v_lshl_add_u32 v11, v11, 4, v2
    v_and_b32 v14, 7, v0
    v_lshlrev_b32 v14, 4, v14
    v_and_b32 v15, 8, v0
    v_add_u32 v14, v14, v15
    v_and_b32 v15, 16, v0
    v_lshl_add_u32 v14, v15, 3, v14
    s_lshl_b32 s39, s41, 8
    v_add_u32 v14, s39, v14
    v_lshrrev_b32 v15, 5, v0
    v_lshl_add_u32 v14, v15, 2, v14
    s_getreg_b32 s49, hwreg(HW_REG_XCC_ID)
    s_waitcnt lgkmcnt(0)
    s_add_u32 s36, s36, 0x9e3779b1
    s_and_b32 s49, s49, 15
    s_and_b32 s46, s36, 0xfffffff0
    s_or_b32 s46, s46, s49
    s_bfe_u32 s60, s46, 0x80000
    s_bfe_u32 s61, s46, 0x80008
    s_bfe_u32 s62, s46, 0x80010
    s_bfe_u32 s63, s46, 0x80018
    s_waitcnt vmcnt(30)
    ds_read_b128 v[64:67], v8 offset:0
    ds_read_b128 v[68:71], v9 offset:0
    ds_read_b128 v[72:75], v10 offset:0
    ds_read_b128 v[76:79], v11 offset:0
    s_waitcnt vmcnt(26)
    ds_read_b128 v[80:83], v8 offset:4096
    ds_read_b128 v[84:87], v9 offset:4096
    ds_read_b128 v[88:91], v10 offset:4096
    ds_read_b128 v[92:95], v11 offset:4096
    s_waitcnt vmcnt(22)
    ds_read_b128 v[96:99], v8 offset:8192
    ds_read_b128 v[100:103], v9 offset:8192
    ds_read_b128 v[104:107], v10 offset:8192
    ds_read_b128 v[108:111], v11 offset:8192
    s_waitcnt vmcnt(18)
    ds_read_b128 v[112:115], v8 offset:12288
    ds_read_b128 v[116:119], v9 offset:12288
    ds_read_b128 v[120:123], v10 offset:12288
    ds_read_b128 v[124:127], v11 offset:12288
    s_waitcnt vmcnt(14)
    ds_read_b128 v[128:131], v8 offset:16384
    ds_read_b128 v[132:135], v9 offset:16384
    ds_read_b128 v[136:139], v10 offset:16384
    ds_read_b128 v[140:143], v11 offset:16384
    s_waitcnt vmcnt(10)
    ds_read_b128 v[144:147], v8 offset:20480
    ds_read_b128 v[148:151], v9 offset:20480
    ds_read_b128 v[152:155], v10 offset:20480
    ds_read_b128 v[156:159], v11 offset:20480
    s_waitcnt vmcnt(6)
    ds_read_b128 v[160:163], v8 offset:24576
    ds_read_b128 v[164:167], v9 offset:24576
    ds_read_b128 v[168:171], v10 offset:24576
    ds_read_b128 v[172:175], v11 offset:24576
    s_waitcnt vmcnt(2)
    ds_read_b128 v[176:179], v8 offset:28672
    ds_read_b128 v[180:183], v9 offset:28672
    ds_read_b128 v[184:187], v10 offset:28672
    ds_read_b128 v[188:191], v11 offset:28672
    s_mov_b32 s54, 100000
    s_waitcnt vmcnt(0)
L_qchk:
    v_xor_b32 v20, s60, v20
    v_xor_b32 v21, s61, v21
    v_xor_b32 v22, s62, v22
    v_xor_b32 v23, s63, v23
    v_xor_b32 v24, s60, v24
    v_xor_b32 v25, s61, v25
    v_xor_b32 v26, s62, v26
    v_xor_b32 v27, s63, v27
    v_or_b32 v28, v20, v24
    v_or3_b32 v29, v21, v22, v23
    v_or3_b32 v29, v29, v25, v26
    v_and_b32 v30, 0xf0, v28
    v_or3_b32 v29, v29, v27, v30
    v_and_b32 v29, 0xff, v29
    v_cmp_ne_u32 vcc, 0, v29
    s_and_b64 exec, exec, vcc
    s_cbranch_execz L_qok
    s_sub_u32 s54, s54, 1
    s_cbranch_scc1 L_qok
    s_setprio 3
    buffer_load_dwordx4 v[20:23], v13, s[32:35], s48 offen sc1
    buffer_load_dwordx4 v[24:27], v13, s[32:35], s48 offen offset:2048 sc1
    s_cmp_eq_u32 s54, 99997
    s_cbranch_scc1 L_qrep1
L_qret1:
    s_waitcnt vmcnt(0)
    s_branch L_qchk
L_qok:
    s_mov_b64 exec, -1
    v_and_b32 v28, 15, v28
    v_and_b32 v20, 0xffffff00, v20
    v_and_b32 v24, 0xffffff00, v24
    v_cmp_ne_u32 vcc, 0, v28
    s_cbranch_vccnz L_qrep2
L_qret2:
    v_pk_add_f32 v[20:21], v[20:21], v[24:25]
    v_pk_add_f32 v[22:23], v[22:23], v[26:27]
    s_nop 1
    v_permlane32_swap_b32 v20, v22
    v_permlane32_swap_b32 v21, v23
    s_cmp_lg_u64 vcc, 0
    s_cselect_b32 s39, 1, 0
    v_mov_b32 v24, s39
    v_pk_add_f32 v[20:21], v[20:21], v[22:23]
    v_cvt_pk_bf16_f32 v20, v20, v21
    ds_write_b32 v14, v20 offset:256
    s_mov_b64 exec, 1
    ds_add_u32 v6, v24 offset:40
    ds_add_u32 v6, v12 offset:0
    s_mov_b64 exec, -1
    s_mov_b32 s54, 800000
L_lp50:
    ds_read_b32 v3, v6 offset:0
    s_waitcnt lgkmcnt(0)
    v_readfirstlane_b32 s39, v3
    s_cmp_eq_u32 s39, 4
    s_cbranch_scc1 L_ld50
    s_sub_u32 s54, s54, 1
    s_cbranch_scc0 L_lp50
L_ld50:
    s_setprio 2
    v_lshlrev_b32 v3, 8, v7
    v_lshl_add_u32 v3, v4, 4, v3
    ds_read_b128 v[16:19], v3 offset:256
    ds_read_b128 v[20:23], v3 offset:320
    ds_read_b128 v[24:27], v3 offset:384
    ds_read_b128 v[28:31], v3 offset:448
    ds_read_b32 v15, v6 offset:40
    s_waitcnt lgkmcnt(0)
    v_readfirstlane_b32 s40, v15
    v_mfma_f32_16x16x32_bf16 v[32:35], v[64:67], v[16:19], 0
    v_mfma_f32_16x16x32_bf16 v[36:39], v[80:83], v[16:19], 0
    v_mfma_f32_16x16x32_bf16 v[40:43], v[96:99], v[16:19], 0
    v_mfma_f32_16x16x32_bf16 v[44:47], v[112:115], v[16:19], 0
    v_mfma_f32_16x16x32_bf16 v[48:51], v[128:131], v[16:19], 0
    v_mfma_f32_16x16x32_bf16 v[52:55], v[144:147], v[16:19], 0
    v_mfma_f32_16x16x32_bf16 v[56:59], v[160:163], v[16:19], 0
    v_mfma_f32_16x16x32_bf16 v[60:63], v[176:179], v[16:19], 0
    v_mfma_f32_16x16x32_bf16 v[32:35], v[68:71], v[20:23], v[32:35]
    v_mfma_f32_16x16x32_bf16 v[36:39], v[84:87], v[20:23], v[36:39]
    v_mfma_f32_16x16x32_bf16 v[40:43], v[100:103], v[20:23], v[40:43]
    v_mfma_f32_16x16x32_bf16 v[44:47], v[116:119], v[20:23], v[44:47]
    v_mfma_f32_16x16x32_bf16 v[48:51], v[132:135], v[20:23], v[48:51]
    v_mfma_f32_16x16x32_bf16 v[52:55], v[148:151], v[20:23], v[52:55]
    v_mfma_f32_16x16x32_bf16 v[56:59], v[164:167], v[20:23], v[56:59]
    v_mfma_f32_16x16x32_bf16 v[60:63], v[180:183], v[20:23], v[60:63]
    v_mfma_f32_16x16x32_bf16 v[32:35], v[72:75], v[24:27], v[32:35]
    v_mfma_f32_16x16x32_bf16 v[36:39], v[88:91], v[24:27], v[36:39]
    v_mfma_f32_16x16x32_bf16 v[40:43], v[104:107], v[24:27], v[40:43]
    v_mfma_f32_16x16x32_bf16 v[44:47], v[120:123], v[24:27], v[44:47]
    v_mfma_f32_16x16x32_bf16 v[48:51], v[136:139], v[24:27], v[48:51]
    v_mfma_f32_16x16x32_bf16 v[52:55], v[152:155], v[24:27], v[52:55]
    v_mfma_f32_16x16x32_bf16 v[56:59], v[168:171], v[24:27], v[56:59]
    v_mfma_f32_16x16x32_bf16 v[60:63], v[184:187], v[24:27], v[60:63]
    v_mfma_f32_16x16x32_bf16 v[32:35], v[76:79], v[28:31], v[32:35]
    v_mfma_f32_16x16x32_bf16 v[36:39], v[92:95], v[28:31], v[36:39]
    v_mfma_f32_16x16x32_bf16 v[40:43], v[108:111], v[28:31], v[40:43]
    v_mfma_f32_16x16x32_bf16 v[44:47], v[124:127], v[28:31], v[44:47]
    v_mfma_f32_16x16x32_bf16 v[48:51], v[140:143], v[28:31], v[48:51]
    v_mfma_f32_16x16x32_bf16 v[52:55], v[156:159], v[28:31], v[52:55]
    v_mfma_f32_16x16x32_bf16 v[56:59], v[172:175], v[28:31], v[56:59]
    v_mfma_f32_16x16x32_bf16 v[60:63], v[188:191], v[28:31], v[60:63]
    s_nop 1
    v_max3_f32 v8, v32, v33, v34
    v_max3_f32 v8, v8, v35, v36
    v_max3_f32 v8, v8, v37, v38
    v_max3_f32 v8, v8, v39, v40
    v_max3_f32 v8, v8, v41, v42
    v_max3_f32 v8, v8, v43, v44
    v_max3_f32 v8, v8, v45, v46
    v_max3_f32 v8, v8, v47, v48
    v_max3_f32 v8, v8, v49, v50
    v_max3_f32 v8, v8, v51, v52
    v_max3_f32 v8, v8, v53, v54
    v_max3_f32 v8, v8, v55, v56
    v_max3_f32 v8, v8, v57, v58
    v_max3_f32 v8, v8, v59, v60
    v_max3_f32 v8, v8, v61, v62
    v_max_f32 v8, v8, v63
    v_mov_b32 v9, v8
    s_nop 1
    v_permlane32_swap_b32 v8, v9
    s_nop 0
    v_max_f32 v8, v8, v9
    v_mov_b32 v9, v8
    s_nop 1
    v_permlane16_swap_b32 v8, v9
    s_nop 0
    v_max_f32 v8, v8, v9
    s_lshl_b32 s39, s41, 2
    v_lshlrev_b32 v10, 4, v7
    v_add_u32 v11, s39, v10
    v_mov_b32 v12, 1
    s_mov_b64 exec, 15
    ds_write_b32 v11, v8 offset:64
    s_mov_b64 exec, 1
    s_waitcnt lgkmcnt(0)
    ds_add_u32 v6, v12 offset:4
    s_mov_b64 exec, -1
    s_mov_b32 s54, 800000
L_lp51:
    ds_read_b32 v3, v6 offset:4
    s_waitcnt lgkmcnt(0)
    v_readfirstlane_b32 s39, v3
    s_cmp_eq_u32 s39, 4
    s_cbranch_scc1 L_ld51
    s_sub_u32 s54, s54, 1
    s_cbranch_scc0 L_lp51
L_ld51:
    ds_read_b128 v[16:19], v10 offset:64
    s_mov_b32 s57, 0x3e0293ee
    s_waitcnt lgkmcnt(0)
    v_max3_f32 v8, v16, v17, v18
    v_max_f32 v8, v8, v19
    v_mul_f32 v8, s57, v8
    v_fma_f32 v32, v32, s57, -v8
    v_fma_f32 v33, v33, s57, -v8
    v_fma_f32 v34, v34, s57, -v8
    v_fma_f32 v35, v35, s57, -v8
    v_fma_f32 v36, v36, s57, -v8
    v_fma_f32 v37, v37, s57, -v8
    v_fma_f32 v38, v38, s57, -v8
    v_fma_f32 v39, v39, s57, -v8
    v_fma_f32 v40, v40, s57, -v8
    v_fma_f32 v41, v41, s57, -v8
    v_fma_f32 v42, v42, s57, -v8
    v_fma_f32 v43, v43, s57, -v8
    v_fma_f32 v44, v44, s57, -v8
    v_fma_f32 v45, v45, s57, -v8
    v_fma_f32 v46, v46, s57, -v8
    v_fma_f32 v47, v47, s57, -v8
    v_fma_f32 v48, v48, s57, -v8
    v_fma_f32 v49, v49, s57, -v8
    v_fma_f32 v50, v50, s57, -v8
    v_fma_f32 v51, v51, s57, -v8
    v_fma_f32 v52, v52, s57, -v8
    v_fma_f32 v53, v53, s57, -v8
    v_fma_f32 v54, v54, s57, -v8
    v_fma_f32 v55, v55, s57, -v8
    v_fma_f32 v56, v56, s57, -v8
    v_fma_f32 v57, v57, s57, -v8
    v_fma_f32 v58, v58, s57, -v8
    v_fma_f32 v59, v59, s57, -v8
    v_fma_f32 v60, v60, s57, -v8
    v_fma_f32 v61, v61, s57, -v8
    v_fma_f32 v62, v62, s57, -v8
    v_fma_f32 v63, v63, s57, -v8
    v_exp_f32 v32, v32
    v_exp_f32 v33, v33
    v_exp_f32 v34, v34
    v_exp_f32 v35, v35
    v_exp_f32 v36, v36
    v_exp_f32 v37, v37
    v_exp_f32 v38, v38
    v_exp_f32 v39, v39
    v_exp_f32 v40, v40
    v_exp_f32 v41, v41
    v_exp_f32 v42, v42
    v_exp_f32 v43, v43
    v_exp_f32 v44, v44
    v_exp_f32 v45, v45
    v_exp_f32 v46, v46
    v_exp_f32 v47, v47
    v_exp_f32 v48, v48
    v_exp_f32 v49, v49
    v_exp_f32 v50, v50
    v_exp_f32 v51, v51
    v_exp_f32 v52, v52
    v_exp_f32 v53, v53
    v_exp_f32 v54, v54
    v_exp_f32 v55, v55
    v_exp_f32 v56, v56
    v_exp_f32 v57, v57
    v_exp_f32 v58, v58
    v_exp_f32 v59, v59
    v_exp_f32 v60, v60
    v_exp_f32 v61, v61
    v_exp_f32 v62, v62
    v_exp_f32 v63, v63
    s_nop 0
    v_cvt_pk_bf16_f32 v16, v32, v33
    v_cvt_pk_bf16_f32 v17, v34, v35
    v_cvt_pk_bf16_f32 v18, v36, v37
    v_cvt_pk_bf16_f32 v19, v38, v39
    v_cvt_pk_bf16_f32 v20, v40, v41
    v_cvt_pk_bf16_f32 v21, v42, v43
    v_cvt_pk_bf16_f32 v22, v44, v45
    v_cvt_pk_bf16_f32 v23, v46, v47
    v_cvt_pk_bf16_f32 v24, v48, v49
    v_cvt_pk_bf16_f32 v25, v50, v51
    v_cvt_pk_bf16_f32 v26, v52, v53
    v_cvt_pk_bf16_f32 v27, v54, v55
    v_cvt_pk_bf16_f32 v28, v56, v57
    v_cvt_pk_bf16_f32 v29, v58, v59
    v_cvt_pk_bf16_f32 v30, v60, v61
    v_cvt_pk_bf16_f32 v31, v62, v63
    v_lshl_add_u32 v13, v0, 4, s45
    ds_write_b128 v13, v[16:19] offset:0
    ds_write_b128 v13, v[20:23] offset:1024
    ds_write_b128 v13, v[24:27] offset:2048
    ds_write_b128 v13, v[28:31] offset:3072
    v_add_f32 v32, v32, v48
    v_add_f32 v33, v33, v49
    v_add_f32 v34, v34, v50
    v_add_f32 v35, v35, v51
    v_add_f32 v36, v36, v52
    v_add_f32 v37, v37, v53
    v_add_f32 v38, v38, v54
    v_add_f32 v39, v39, v55
    v_add_f32 v40, v40, v56
    v_add_f32 v41, v41, v57
    v_add_f32 v42, v42, v58
    v_add_f32 v43, v43, v59
    v_add_f32 v44, v44, v60
    v_add_f32 v45, v45, v61
    v_add_f32 v46, v46, v62
    v_add_f32 v47, v47, v63
    s_mov_b64 exec, 1
    s_waitcnt lgkmcnt(0)
    ds_write_b32 v11, v12 offset:16
    s_mov_b64 exec, -1
    v_add_f32 v32, v32, v40
    v_add_f32 v33, v33, v41
    v_add_f32 v34, v34, v42
    v_add_f32 v35, v35, v43
    v_add_f32 v36, v36, v44
    v_add_f32 v37, v37, v45
    v_add_f32 v38, v38, v46
    v_add_f32 v39, v39, v47
    v_add_f32 v32, v32, v36
    v_add_f32 v33, v33, v37
    v_add_f32 v34, v34, v38
    v_add_f32 v35, v35, v39
    v_add_f32 v32, v32, v34
    v_add_f32 v33, v33, v35
    v_add_f32 v32, v32, v33
    v_mov_b32 v9, v32
    s_nop 1
    v_permlane32_swap_b32 v32, v9
    s_nop 0
    v_add_f32 v32, v32, v9
    v_mov_b32 v9, v32
    s_nop 1
    v_permlane16_swap_b32 v32, v9
    s_nop 0
    v_add_f32 v32, v32, v9
    s_mov_b64 exec, 15
    ds_write_b32 v11, v32 offset:128
    s_mov_b64 exec, 1
    s_waitcnt lgkmcnt(0)
    ds_add_u32 v6, v12 offset:8
    s_mov_b64 exec, -1
    v_lshlrev_b32 v2, 4, v0
    s_lshr_b32 s44, s5, 3
    s_and_b32 s45, s5, 7
    s_lshl_b32 s46, s4, 2
    s_add_u32 s46, s46, s44
    s_lshl_b32 s47, s46, 13
    s_lshl_b32 s39, s41, 11
    s_add_u32 s47, s47, s39
    s_add_u32 s47, s47, 0x50000
    s_lshl_b32 s42, s4, 11
    s_add_u32 s42, s42, 0x44000
    s_cmp_lg_u32 s3, 4
    s_cbranch_scc1 L_k_noml
    s_mov_b32 s54, 800000
L_lp52:
    ds_read_b32 v3, v6 offset:8
    s_waitcnt lgkmcnt(0)
    v_readfirstlane_b32 s39, v3
    s_cmp_eq_u32 s39, 4
    s_cbranch_scc1 L_ld52
    s_sub_u32 s54, s54, 1
    s_cbranch_scc0 L_lp52
L_ld52:
    ds_read_b128 v[16:19], v10 offset:128
    v_mov_b32 v21, s36
    v_mov_b32 v23, s36
    v_mov_b32 v20, v8
    s_lshl_b32 s43, s5, 4
    s_add_u32 s43, s43, s42
    v_lshlrev_b32 v14, 9, v7
    s_waitcnt lgkmcnt(0)
    v_add_f32 v16, v16, v17
    v_add_f32 v18, v18, v19
    v_add_f32 v22, v16, v18
    s_mov_b64 exec, 15
    s_cmp_eq_u32 s40, 0
    s_cbranch_scc1 L_ml_fast
    buffer_store_dwordx4 v[20:23], v14, s[32:35], s43 offen sc1
    s_branch L_ml_done
L_ml_fast:
    buffer_store_dwordx4 v[20:23], v14, s[32:35], s43 offen
L_ml_done:
    s_mov_b64 exec, -1
L_k_noml:
    s_lshl_b32 s39, s44, 9
    s_add_u32 s48, s42, s39
    v_and_b32 v16, 7, v0
    v_lshlrev_b32 v16, 4, v16
    v_lshl_add_u32 v16, v4, 7, v16
    s_setprio 0
    s_lshl_b32 s43, s46, 17
    s_lshl_b32 s39, s41, 15
    s_add_u32 s43, s43, s39
    s_lshl_b32 s39, s45, 7
    s_add_u32 s43, s43, s39
    v_lshrrev_b32 v14, 3, v0
    v_lshlrev_b32 v14, 10, v14
    v_and_b32 v15, 7, v0
    v_lshl_add_u32 v14, v15, 4, v14
    s_lshl_b32 s49, s41, 15
    s_add_u32 s49, s49, 0x5000
    v_lshlrev_b32 v17, 8, v4
    v_lshl_add_u32 v17, v5, 3, v17
    v_add_u32 v17, s49, v17
    s_mov_b32 s54, 800000
L_lp53:
    ds_read_b32 v3, v6 offset:32
    s_waitcnt lgkmcnt(0)
    v_readfirstlane_b32 s39, v3
    s_cmp_eq_u32 s39, 4
    s_cbranch_scc1 L_ld53
    s_sleep 1
    s_sub_u32 s54, s54, 1
    s_cbranch_scc0 L_lp53
L_ld53:
    s_add_u32 m0, s49, 0
    s_nop 0
    buffer_load_dwordx4 v14, s[24:27], s43 offen nt lds
    s_add_u32 m0, s49, 1024
    s_add_u32 s43, s43, 8192
    buffer_load_dwordx4 v14, s[24:27], s43 offen nt lds
    s_add_u32 m0, s49, 2048
    s_add_u32 s43, s43, 8192
    buffer_load_dwordx4 v14, s[24:27], s43 offen nt lds
    s_add_u32 m0, s49, 3072
    s_add_u32 s43, s43, 8192
    buffer_load_dwordx4 v14, s[24:27], s43 offen nt lds
    s_lshl_b32 s39, s41, 10
    v_add_u32 v13, s39, v2
    v_lshrrev_b32 v15, 3, v5
    v_lshl_add_u32 v15, v4, 4, v15
    v_lshlrev_b32 v15, 12, v15
    v_and_b32 v14, 7, v0
    v_lshl_add_u32 v15, v14, 4, v15
    s_lshl_b32 s43, s45, 13
    s_lshl3_add_u32 s39, s44, s4
    s_lshl_b32 s39, s39, 7
    s_add_u32 s43, s43, s39
    s_add_u32 s43, s43, 0x90000
    s_bfe_u32 s60, s36, 0x80000
    s_bfe_u32 s61, s36, 0x80008
    s_bfe_u32 s62, s36, 0x80010
    s_bfe_u32 s63, s36, 0x80018
    v_mov_b32 v44, s60
    v_mov_b32 v45, s61
    v_mov_b32 v46, s62
    v_mov_b32 v47, s63
    s_mov_b32 s59, 0xffffff00
    v_lshlrev_b32 v14, 3, v14
    v_lshl_add_u32 v14, v4, 1, v14
    s_add_u32 s39, s2, 0
    s_and_b32 s39, s39, 7
    s_and_b32 s42, s2, 0xf8
    s_or_b32 s42, s42, s39
    s_lshl_b32 s58, s42, 6
    s_lshl_b32 s42, s42, 12
    s_add_u32 s42, s42, 0x90000
    s_mov_b32 s54, 100000
L_gp54:
    buffer_load_dwordx4 v[24:27], v16, s[32:35], s48 offen sc1
    s_waitcnt vmcnt(0)
    v_cmp_ne_u32 vcc, s36, v25
    v_cmp_ne_u32 s[50:51], s36, v27
    s_or_b64 vcc, vcc, s[50:51]
    s_and_b64 exec, exec, vcc
    s_cbranch_execz L_gd54
    s_sub_u32 s54, s54, 1
    s_cbranch_scc0 L_gp54
L_gd54:
    s_mov_b64 exec, -1
    ds_read_b64 v[64:65], v17 offset:0
    ds_read_b64 v[66:67], v17 offset:1024
    ds_read_b64 v[68:69], v17 offset:2048
    ds_read_b64 v[70:71], v17 offset:3072
    ds_read_b64 v[72:73], v17 offset:128
    ds_read_b64 v[74:75], v17 offset:1152
    ds_read_b64 v[76:77], v17 offset:2176
    ds_read_b64 v[78:79], v17 offset:3200
    v_max_f32 v28, v24, v24 row_ror:4
    s_nop 1
    v_max_f32 v28, v28, v28 row_ror:2
    s_nop 1
    v_max_f32 v28, v28, v28 row_ror:1
    v_sub_f32 v30, v24, v28
    v_exp_f32 v30, v30
    s_nop 0
    v_mul_f32 v29, v30, v26
    s_nop 1
    v_add_f32 v29, v29, v29 row_ror:4
    s_nop 1
    v_add_f32 v29, v29, v29 row_ror:2
    s_nop 1
    v_add_f32 v29, v29, v29 row_ror:1
    v_rcp_f32 v29, v29
    s_nop 0
    v_mul_f32 v30, v30, v29
    s_waitcnt lgkmcnt(0)
    v_perm_b32 v80, v66, v64, s55
    v_perm_b32 v81, v70, v68, s55
    v_perm_b32 v82, v74, v72, s55
    v_perm_b32 v83, v78, v76, s55
    v_perm_b32 v84, v66, v64, s56
    v_perm_b32 v85, v70, v68, s56
    v_perm_b32 v86, v74, v72, s56
    v_perm_b32 v87, v78, v76, s56
    v_perm_b32 v88, v67, v65, s55
    v_perm_b32 v89, v71, v69, s55
    v_perm_b32 v90, v75, v73, s55
    v_perm_b32 v91, v79, v77, s55
    v_perm_b32 v92, v67, v65, s56
    v_perm_b32 v93, v71, v69, s56
    v_perm_b32 v94, v75, v73, s56
    v_perm_b32 v95, v79, v77, s56
    v_mov_b32 v32, v30 row_newbcast:0 row_mask:0xf bank_mask:0xf
    v_mov_b32 v33, v30 row_newbcast:1 row_mask:0xf bank_mask:0xf
    v_mov_b32 v34, v30 row_newbcast:2 row_mask:0xf bank_mask:0xf
    v_mov_b32 v35, v30 row_newbcast:3 row_mask:0xf bank_mask:0xf
    v_mov_b32 v36, v30 row_newbcast:4 row_mask:0xf bank_mask:0xf
    v_mov_b32 v37, v30 row_newbcast:5 row_mask:0xf bank_mask:0xf
    v_mov_b32 v38, v30 row_newbcast:6 row_mask:0xf bank_mask:0xf
    v_mov_b32 v39, v30 row_newbcast:7 row_mask:0xf bank_mask:0xf
    s_mov_b32 s54, 800000
L_lp55:
    ds_read_b32 v3, v6 offset:44
    s_waitcnt lgkmcnt(0)
    v_readfirstlane_b32 s39, v3
    s_cmp_ge_u32 s39, 4
    s_cbranch_scc1 L_ld55
    s_sub_u32 s54, s54, 1
    s_cbranch_scc0 L_lp55
L_ld55:
    s_cmp_lg_u32 s40, 0
    s_cbranch_scc1 L_k_slow
    s_mov_b32 s54, 100000
L_gp56:
    buffer_load_dwordx4 v[96:99], v2, s[32:35], s47 offen sc1
    buffer_load_dwordx4 v[100:103], v2, s[32:35], s47 offen offset:1024 sc1
    s_waitcnt vmcnt(0)
    v_max3_u32 v112, v96, v99, v100
    v_max_u32 v112, v112, v103
    v_cmp_eq_u32 vcc, -1, v112
    s_and_b64 exec, exec, vcc
    s_cbranch_execz L_gd56
    s_sub_u32 s54, s54, 1
    s_cbranch_scc0 L_gp56
L_gd56:
    s_mov_b64 exec, -1
L_kjoin:
    v_mfma_f32_16x16x32_bf16 v[136:139], v[96:99], v[80:83], 0
    v_mfma_f32_16x16x32_bf16 v[144:147], v[96:99], v[84:87], 0
    v_mfma_f32_16x16x32_bf16 v[152:155], v[96:99], v[88:91], 0
    v_mfma_f32_16x16x32_bf16 v[160:163], v[96:99], v[92:95], 0
    v_mfma_f32_16x16x32_bf16 v[140:143], v[100:103], v[80:83], 0
    v_mfma_f32_16x16x32_bf16 v[148:151], v[100:103], v[84:87], 0
    v_mfma_f32_16x16x32_bf16 v[156:159], v[100:103], v[88:91], 0
    v_mfma_f32_16x16x32_bf16 v[164:167], v[100:103], v[92:95], 0
    s_nop 0
    v_pk_mul_f32 v[136:137], v[136:137], v[32:33]
    v_pk_mul_f32 v[144:145], v[144:145], v[32:33]
    v_pk_mul_f32 v[152:153], v[152:153], v[32:33]
    v_pk_mul_f32 v[160:161], v[160:161], v[32:33]
    v_pk_fma_f32 v[136:137], v[138:139], v[34:35], v[136:137]
    v_pk_fma_f32 v[144:145], v[146:147], v[34:35], v[144:145]
    v_pk_fma_f32 v[152:153], v[154:155], v[34:35], v[152:153]
    v_pk_fma_f32 v[160:161], v[162:163], v[34:35], v[160:161]
    v_pk_fma_f32 v[136:137], v[140:141], v[36:37], v[136:137]
    v_pk_fma_f32 v[144:145], v[148:149], v[36:37], v[144:145]
    v_pk_fma_f32 v[152:153], v[156:157], v[36:37], v[152:153]
    v_pk_fma_f32 v[160:161], v[164:165], v[36:37], v[160:161]
    v_pk_fma_f32 v[136:137], v[142:143], v[38:39], v[136:137]
    v_pk_fma_f32 v[144:145], v[150:151], v[38:39], v[144:145]
    v_pk_fma_f32 v[152:153], v[158:159], v[38:39], v[152:153]
    v_pk_fma_f32 v[160:161], v[166:167], v[38:39], v[160:161]
    v_add_f32 v128, v136, v137
    v_add_f32 v129, v144, v145
    v_add_f32 v130, v152, v153
    v_add_f32 v131, v160, v161
    ds_write_b128 v13, v[128:131] offset:4096
    s_mov_b64 exec, 1
    ds_add_rtn_u32 v3, v6, v12 offset:48
    s_mov_b64 exec, -1
    ds_read_b128 v[16:19], v2 offset:4096
    ds_read_b128 v[20:23], v2 offset:5120
    ds_read_b128 v[24:27], v2 offset:6144
    ds_read_b128 v[28:31], v2 offset:7168
    s_waitcnt lgkmcnt(4)
    v_readfirstlane_b32 s39, v3
    s_cmp_lg_u32 s39, 3
    s_cbranch_scc1 L_fin
    s_waitcnt lgkmcnt(2)
    v_pk_add_f32 v[16:17], v[16:17], v[20:21]
    v_pk_add_f32 v[18:19], v[18:19], v[22:23]
    s_waitcnt lgkmcnt(0)
    v_pk_add_f32 v[24:25], v[24:25], v[28:29]
    v_pk_add_f32 v[26:27], v[26:27], v[30:31]
    v_pk_add_f32 v[128:129], v[16:17], v[24:25]
    v_pk_add_f32 v[130:131], v[18:19], v[26:27]
    v_and_or_b32 v128, v128, s59, v44
    v_and_or_b32 v129, v129, s59, v45
    v_and_or_b32 v130, v130, s59, v46
    v_and_or_b32 v131, v131, s59, v47
    buffer_store_dwordx4 v[128:131], v15, s[32:35], s43 offen sc1
    s_cmp_ge_u32 s58, 4096
    s_cbranch_scc1 L_fin
    s_waitcnt vmcnt(0)
    s_mov_b32 s54, 100000
    buffer_load_dwordx4 v[192:195], v2, s[32:35], s42 offen offset:0 sc1
    buffer_load_dwordx4 v[196:199], v2, s[32:35], s42 offen offset:1024 sc1
    buffer_load_dwordx4 v[200:203], v2, s[32:35], s42 offen offset:2048 sc1
    buffer_load_dwordx4 v[204:207], v2, s[32:35], s42 offen offset:3072 sc1
    s_mov_b64 s[50:51], -1
    s_mov_b64 s[52:53], -1
    s_sleep 6
L_dp57:
    buffer_load_dwordx4 v[208:211], v2, s[32:35], s42 offen offset:0 sc1
    buffer_load_dwordx4 v[212:215], v2, s[32:35], s42 offen offset:1024 sc1
    buffer_load_dwordx4 v[216:219], v2, s[32:35], s42 offen offset:2048 sc1
    buffer_load_dwordx4 v[220:223], v2, s[32:35], s42 offen offset:3072 sc1
    s_mov_b64 exec, s[50:51]
    s_waitcnt vmcnt(4)
    v_xor_b32 v192, v44, v192
    v_xor_b32 v193, v45, v193
    v_xor_b32 v194, v46, v194
    v_xor_b32 v195, v47, v195
    v_xor_b32 v196, v44, v196
    v_xor_b32 v197, v45, v197
    v_xor_b32 v198, v46, v198
    v_xor_b32 v199, v47, v199
    v_xor_b32 v200, v44, v200
    v_xor_b32 v201, v45, v201
    v_xor_b32 v202, v46, v202
    v_xor_b32 v203, v47, v203
    v_xor_b32 v204, v44, v204
    v_xor_b32 v205, v45, v205
    v_xor_b32 v206, v46, v206
    v_xor_b32 v207, v47, v207
    v_or3_b32 v112, v192, v193, v194
    v_or3_b32 v112, v112, v195, v196
    v_or3_b32 v112, v112, v197, v198
    v_or3_b32 v112, v112, v199, v200
    v_or3_b32 v112, v112, v201, v202
    v_or3_b32 v112, v112, v203, v204
    v_or3_b32 v112, v112, v205, v206
    v_or_b32 v112, v112, v207
    v_and_b32 v112, 0xff, v112
    v_cmp_ne_u32 vcc, 0, v112
    s_and_b64 exec, exec, vcc
    s_cbranch_execz L_dA57
    s_mov_b64 s[50:51], exec
    buffer_load_dwordx4 v[192:195], v2, s[32:35], s42 offen offset:0 sc1
    buffer_load_dwordx4 v[196:199], v2, s[32:35], s42 offen offset:1024 sc1
    buffer_load_dwordx4 v[200:203], v2, s[32:35], s42 offen offset:2048 sc1
    buffer_load_dwordx4 v[204:207], v2, s[32:35], s42 offen offset:3072 sc1
    s_mov_b64 exec, s[52:53]
    s_waitcnt vmcnt(4)
    v_xor_b32 v208, v44, v208
    v_xor_b32 v209, v45, v209
    v_xor_b32 v210, v46, v210
    v_xor_b32 v211, v47, v211
    v_xor_b32 v212, v44, v212
    v_xor_b32 v213, v45, v213
    v_xor_b32 v214, v46, v214
    v_xor_b32 v215, v47, v215
    v_xor_b32 v216, v44, v216
    v_xor_b32 v217, v45, v217
    v_xor_b32 v218, v46, v218
    v_xor_b32 v219, v47, v219
    v_xor_b32 v220, v44, v220
    v_xor_b32 v221, v45, v221
    v_xor_b32 v222, v46, v222
    v_xor_b32 v223, v47, v223
    v_or3_b32 v112, v208, v209, v210
    v_or3_b32 v112, v112, v211, v212
    v_or3_b32 v112, v112, v213, v214
    v_or3_b32 v112, v112, v215, v216
    v_or3_b32 v112, v112, v217, v218
    v_or3_b32 v112, v112, v219, v220
    v_or3_b32 v112, v112, v221, v222
    v_or_b32 v112, v112, v223
    v_and_b32 v112, 0xff, v112
    v_cmp_ne_u32 vcc, 0, v112
    s_and_b64 exec, exec, vcc
    s_cbranch_execz L_dB57
    s_mov_b64 s[52:53], exec
    s_sub_u32 s54, s54, 1
    s_cbranch_scc0 L_dp57
L_dB57:
    s_mov_b64 exec, -1
    v_pk_add_f32 v[16:17], v[208:209], v[216:217]
    v_pk_add_f32 v[18:19], v[210:211], v[218:219]
    v_pk_add_f32 v[20:21], v[212:213], v[220:221]
    v_pk_add_f32 v[22:23], v[214:215], v[222:223]
    s_branch L_dJ57
L_dA57:
    s_mov_b64 exec, -1
    v_pk_add_f32 v[16:17], v[192:193], v[200:201]
    v_pk_add_f32 v[18:19], v[194:195], v[202:203]
    v_pk_add_f32 v[20:21], v[196:197], v[204:205]
    v_pk_add_f32 v[22:23], v[198:199], v[206:207]
L_dJ57:
    v_pk_add_f32 v[16:17], v[16:17], v[20:21]
    v_pk_add_f32 v[18:19], v[18:19], v[22:23]
    s_nop 1
    v_permlane32_swap_b32 v16, v18
    v_permlane32_swap_b32 v17, v19
    s_nop 0
    v_pk_add_f32 v[16:17], v[16:17], v[18:19]
    s_nop 1
    v_permlane16_swap_b32 v16, v17
    s_nop 0
    v_add_f32 v16, v16, v17
    s_nop 1
    v_add_f32 v16, v16, v16 row_ror:8
    v_cvt_pk_bf16_f32 v16, v16, v16
    s_mov_b32 exec_lo, 0xff00ff
    s_mov_b32 exec_hi, 0xff00ff
    buffer_store_short v16, v14, s[28:31], s58 offen
    s_cmp_lg_u32 s58, 0
    s_cbranch_scc1 L_fin
    s_mov_b64 exec, 1
    v_mov_b32 v17, s36
    buffer_store_dword v17, v6, s[32:35], 0 offen sc1
    s_branch L_fin
L_k_slow:
    v_and_b32 v113, 31, v0
    v_lshlrev_b32 v113, 2, v113
    s_lshl_b32 s39, s4, 7
    s_add_u32 s39, s39, 0x48000
    s_mov_b32 s54, 100000
L_gp58:
    buffer_load_dword v114, v113, s[32:35], s39 offen sc1
    s_waitcnt vmcnt(0)
    v_cmp_ne_u32 vcc, s36, v114
    s_and_b64 exec, exec, vcc
    s_cbranch_execz L_gd58
    s_sleep 1
    s_sub_u32 s54, s54, 1
    s_cbranch_scc0 L_gp58
L_gd58:
    s_mov_b64 exec, -1
    s_add_u32 s47, s47, 0x80000
    buffer_load_dwordx4 v[96:99], v2, s[32:35], s47 offen sc1
    buffer_load_dwordx4 v[100:103], v2, s[32:35], s47 offen offset:1024 sc1
    s_waitcnt vmcnt(0)
    s_branch L_kjoin
L_qrep1:
    s_mov_b64 s[50:51], exec
    s_mov_b64 s[52:53], vcc
    s_mov_b64 exec, -1
    v_lshlrev_b32 v40, 13, v4
    v_lshl_add_u32 v40, v5, 4, v40
    s_lshl_b32 s42, s4, 15
    s_and_b32 s39, s5, 3
    s_lshl_b32 s39, s39, 11
    s_add_u32 s42, s42, s39
    s_lshr_b32 s39, s5, 2
    s_lshl_b32 s39, s39, 8
    s_add_u32 s42, s42, s39
    s_add_u32 s42, s42, 0x1000
    s_mov_b32 s43, 100000
L_qrl1:
    buffer_load_dwordx4 v[32:35], v40, s[32:35], s42 offen sc1
    s_waitcnt vmcnt(0)
    v_xor_b32 v36, s60, v32
    v_xor_b32 v37, s61, v33
    v_xor_b32 v38, s62, v34
    v_xor_b32 v39, s63, v35
    v_or3_b32 v36, v36, v37, v38
    v_or_b32 v36, v36, v39
    v_and_b32 v36, 0xff, v36
    v_cmp_ne_u32 vcc, 0, v36
    s_cbranch_vccz L_qrs1
    s_sub_u32 s43, s43, 1
    s_cbranch_scc0 L_qrl1
L_qrs1:
    buffer_store_dwordx4 v[32:35], v40, s[32:35], s42 offen sc1
    s_waitcnt vmcnt(0)
    s_mov_b64 exec, s[50:51]
    s_mov_b64 vcc, s[52:53]
    s_branch L_qret1
L_qrep2:
    s_mov_b64 s[50:51], exec
    s_mov_b64 s[52:53], vcc
    s_mov_b64 exec, -1
    v_lshlrev_b32 v40, 13, v4
    v_lshl_add_u32 v40, v5, 4, v40
    s_lshl_b32 s42, s4, 15
    s_and_b32 s39, s5, 3
    s_lshl_b32 s39, s39, 11
    s_add_u32 s42, s42, s39
    s_lshr_b32 s39, s5, 2
    s_lshl_b32 s39, s39, 8
    s_add_u32 s42, s42, s39
    s_add_u32 s42, s42, 0x1000
    s_mov_b32 s43, 100000
L_qrl2:
    buffer_load_dwordx4 v[32:35], v40, s[32:35], s42 offen sc1
    s_waitcnt vmcnt(0)
    v_xor_b32 v36, s60, v32
    v_xor_b32 v37, s61, v33
    v_xor_b32 v38, s62, v34
    v_xor_b32 v39, s63, v35
    v_or3_b32 v36, v36, v37, v38
    v_or_b32 v36, v36, v39
    v_and_b32 v36, 0xff, v36
    v_cmp_ne_u32 vcc, 0, v36
    s_cbranch_vccz L_qrs2
    s_sub_u32 s43, s43, 1
    s_cbranch_scc0 L_qrl2
L_qrs2:
    buffer_store_dwordx4 v[32:35], v40, s[32:35], s42 offen sc1
    s_waitcnt vmcnt(0)
    s_mov_b64 exec, s[50:51]
    s_mov_b64 vcc, s[52:53]
    s_branch L_qret2
L_fin:
L_end:
L_last:
    s_endpgm
.section .rodata,"a"
.p2align 6
.amdhsa_kernel standalone__sliding_block_cached__decode_kernel
  .amdhsa_next_free_vgpr 256
  .amdhsa_next_free_sgpr 102
  .amdhsa_accum_offset 256
  .amdhsa_group_segment_fixed_size 0
  .amdhsa_kernarg_size 64
  .amdhsa_user_sgpr_count 2
  .amdhsa_user_sgpr_kernarg_segment_ptr 1
  .amdhsa_system_sgpr_workgroup_id_x 1
  .amdhsa_float_denorm_mode_32 3
.end_amdhsa_kernel
```
